```python
import torch

def _softmax(x, axis=-1):
    return torch.softmax(x, dim=axis)
def _gelu(x):
    return torch.nn.functional.gelu(x, approximate="tanh")
def _silu(x):
    return torch.nn.functional.silu(x)
def _sigmoid(x):
    return torch.sigmoid(x)
def _layernorm(x, axis=-1, eps=1e-5):
    m = x.mean(dim=axis, keepdim=True)
    v = x.var(dim=axis, keepdim=True, unbiased=False)
    return (x - m) / torch.sqrt(v + eps)
def _scatter_add(tgt, idx, src, axis=0):
    return tgt.clone().index_add_(axis, idx, src)
def _segment_sum(src, seg, n):
    out = torch.zeros((n,) + src.shape[1:], dtype=src.dtype)
    return out.index_add_(0, seg, src)
def _pad(x, pw):
    flat = tuple(v for pair in reversed(pw) for v in pair)
    return torch.nn.functional.pad(x, flat)

kernel_name = 'standalone__glu_gated_glu__sampling'

def setup_inputs():

    _w = (lambda a: (lambda t: t.to(torch.bfloat16) if t.is_floating_point() else t)(torch.as_tensor(a)))
    B, S, D, F = 8, 8, 1024, 3584
    return {
        "x": _w((lambda *s: torch.randn(*s, dtype=torch.bfloat16) * 0.1)(B, S, D)),
        "w_gate": _w((lambda *s: torch.randn(*s, dtype=torch.bfloat16) * 0.1)(D, F)),
        "w_up": _w((lambda *s: torch.randn(*s, dtype=torch.bfloat16) * 0.05)(D, F)),
        "w_down": _w((lambda *s: torch.randn(*s, dtype=torch.bfloat16) * 0.05)(F, D)),
    }

def reference(x, w_gate, w_up, w_down):
    g = torch.einsum("bsd,df->bsf", x, w_gate)
    u = torch.einsum("bsd,df->bsf", x, w_up)
    h = _sigmoid(g) * u
    return torch.einsum("bsf,fd->bsd", h, w_down)
```

```asm
; @launch grid=(256,1,1) block=(384,1,1) lds=98304
.amdgcn_target "amdgcn-amd-amdhsa--gfx950"
.text
.globl standalone__glu_gated_glu__sampling_kernel
.p2align 8
.type standalone__glu_gated_glu__sampling_kernel,@function
standalone__glu_gated_glu__sampling_kernel:
  s_load_dwordx8 s[4:11], s[0:1], 0
  s_load_dwordx4 s[12:15], s[0:1], 32
  s_load_dwordx2 s[16:17], s[0:1], 48
  s_and_b32 s18, s2, 0x38
  s_cbranch_scc1 k_noct
  s_getpc_b64 s[18:19]
k_pc:
  s_sub_u32 s18, s18, k_pc-standalone__glu_gated_glu__sampling_kernel
  s_subb_u32 s19, s19, 0
  v_lshlrev_b32 v4, 7, v0
  v_min_u32 v4, k_end-standalone__glu_gated_glu__sampling_kernel, v4
  v_mov_b32 v3, s19
  v_add_co_u32 v2, vcc, s18, v4
  v_addc_co_u32 v3, vcc, 0, v3, vcc
  global_load_dword v150, v[2:3], off
k_noct:
  v_lshrrev_b32 v1, 6, v0
  s_and_b32 s47, s2, 7
  s_lshr_b32 s46, s2, 3
  v_readfirstlane_b32 s3, v1
  v_and_b32 v0, 63, v0
  s_cmp_ge_u32 s2, 256
  s_cbranch_scc1 k_exit
  s_sub_u32 s45, s46, 16
  s_cmp_lt_u32 s3, 2
  s_cbranch_scc0 k_mfma
  s_cmp_ge_u32 s46, 14
  s_cbranch_scc0 k_p1l
  s_cmp_eq_u32 s3, 0
  s_cbranch_scc0 k_exit
  s_cmp_ge_u32 s46, 16
  s_cbranch_scc1 k_p2l
  s_branch k_xh0
k_mfma:
  s_waitcnt lgkmcnt(0)
  s_cmp_ge_u32 s46, 16
  s_cbranch_scc1 k_p2c
  s_cmp_ge_u32 s46, 14
  s_cbranch_scc1 xh_w
  s_branch k_p1c
k_p1l:
  s_mul_i32 s44, s47, 7
  s_lshr_b32 s45, s46, 1
  s_add_u32 s44, s44, s45
  s_and_b32 s45, s46, 1
  v_lshrrev_b32 v1, 3, v0
  v_and_b32 v2, 7, v0
  v_lshrrev_b32 v3, 4, v0
  v_and_b32 v4, 1, v3
  v_lshlrev_b32 v4, 1, v4
  v_xor_b32 v4, v2, v4
  v_mul_u32_u24 v5, 7168, v1
  s_lshl_b32 s51, s44, 7
  v_add_u32 v5, s51, v5
  v_lshl_add_u32 v10, v4, 4, v5
  v_xor_b32 v4, 4, v4
  v_lshl_add_u32 v6, v4, 4, v5
  v_add_u32 v11, 56320, v6
  v_add_u32 v12, 112640, v10
  v_add_u32 v13, 168960, v6
  v_xor_b32 v4, v2, v3
  s_lshl_b32 s49, s45, 16
  s_lshl_b32 s50, s3, 15
  s_add_u32 s49, s49, s50
  v_lshlrev_b32 v5, 11, v1
  v_add_u32 v5, s49, v5
  v_lshl_add_u32 v14, v4, 4, v5
  v_xor_b32 v4, 4, v4
  v_lshl_add_u32 v6, v4, 4, v5
  v_add_u32 v15, 15360, v6
  s_lshl_b32 s52, s3, 13
  s_mul_i32 s53, s3, -6144
  s_add_u32 s53, s53, 16384
  s_add_u32 s58, s52, 81920
  s_mov_b32 s59, s52
  s_mov_b32 s54, 0
  s_mov_b32 s56, 0
  s_mov_b32 s57, 0
  s_waitcnt lgkmcnt(0)
  s_cmp_eq_u32 s3, 0
  s_cselect_b32 s6, s6, s8
  s_cselect_b32 s7, s7, s9
  s_mov_b32 s24, s6
  s_and_b32 s25, s7, 0xffff
  s_mov_b32 s26, 7340032
  s_mov_b32 s27, 0x20000
  s_mov_b32 s20, s4
  s_and_b32 s21, s5, 0xffff
  s_mov_b32 s22, 131072
  s_mov_b32 s23, 0x20000
  s_add_u32 m0, s52, s53
  s_nop 0
p1l_pro:
  buffer_load_dwordx4 v14, s[20:23], s56 offen lds
  buffer_load_dwordx4 v15, s[20:23], s56 offen offset:1024 lds
  s_mov_b32 m0, s52
  s_add_u32 s55, s54, 229376
  buffer_load_dwordx4 v10, s[24:27], s54 offen lds
  buffer_load_dwordx4 v11, s[24:27], s54 offen offset:1024 lds
  buffer_load_dwordx4 v12, s[24:27], s54 offen offset:2048 lds
  buffer_load_dwordx4 v13, s[24:27], s54 offen offset:3072 lds
  s_add_u32 m0, s52, 4096
  s_add_u32 s54, s54, 458752
  s_add_u32 s56, s56, 128
  s_add_u32 s52, s52, 20480
  s_cmp_eq_u32 s52, s58
  s_cselect_b32 s52, s59, s52
  s_add_u32 s60, s52, s53
  s_add_u32 s57, s57, 1
  s_cmp_lt_u32 s57, 3
  s_cbranch_scc0 p1l_loop
  buffer_load_dwordx4 v10, s[24:27], s55 offen lds
  buffer_load_dwordx4 v11, s[24:27], s55 offen offset:1024 lds
  buffer_load_dwordx4 v12, s[24:27], s55 offen offset:2048 lds
  buffer_load_dwordx4 v13, s[24:27], s55 offen offset:3072 lds
  s_mov_b32 m0, s60
  s_branch p1l_pro
p1l_loop:
  buffer_load_dwordx4 v10, s[24:27], s55 offen lds
  buffer_load_dwordx4 v11, s[24:27], s55 offen offset:1024 lds
  buffer_load_dwordx4 v12, s[24:27], s55 offen offset:2048 lds
  buffer_load_dwordx4 v13, s[24:27], s55 offen offset:3072 lds
  s_mov_b32 m0, s60
  s_waitcnt vmcnt(20)
  s_barrier
  buffer_load_dwordx4 v14, s[20:23], s56 offen lds
  buffer_load_dwordx4 v15, s[20:23], s56 offen offset:1024 lds
  s_mov_b32 m0, s52
  s_add_u32 s55, s54, 229376
  buffer_load_dwordx4 v10, s[24:27], s54 offen lds
  buffer_load_dwordx4 v11, s[24:27], s54 offen offset:1024 lds
  buffer_load_dwordx4 v12, s[24:27], s54 offen offset:2048 lds
  buffer_load_dwordx4 v13, s[24:27], s54 offen offset:3072 lds
  s_add_u32 m0, s52, 4096
  s_add_u32 s54, s54, 458752
  s_add_u32 s56, s56, 128
  s_add_u32 s52, s52, 20480
  s_cmp_eq_u32 s52, s58
  s_cselect_b32 s52, s59, s52
  s_add_u32 s60, s52, s53
  s_add_u32 s57, s57, 1
  s_cmp_lt_u32 s57, 16
  s_cbranch_scc1 p1l_loop
  buffer_load_dwordx4 v10, s[24:27], s55 offen lds
  buffer_load_dwordx4 v11, s[24:27], s55 offen offset:1024 lds
  buffer_load_dwordx4 v12, s[24:27], s55 offen offset:2048 lds
  buffer_load_dwordx4 v13, s[24:27], s55 offen offset:3072 lds
  s_waitcnt vmcnt(20)
  s_barrier
  s_waitcnt vmcnt(10)
  s_barrier
  s_waitcnt vmcnt(0)
  s_barrier
  s_endpgm
k_p2l:
  v_mul_u32_u24 v1, 37, v0
  v_lshrrev_b32 v1, 8, v1
  v_mul_u32_u24 v2, 7, v1
  v_sub_u32 v2, v0, v2
  v_mul_u32_u24 v1, 7168, v1
  v_lshl_add_u32 v1, v2, 7, v1
  s_mul_i32 s48, s47, 896
  v_add_u32 v1, s48, v1
  s_mul_i32 s49, s45, 57344
  s_add_u32 s49, s49, 917504
  v_lshlrev_b32 v2, 11, v0
  s_lshl_b32 s50, s45, 7
  s_mov_b32 s53, 0
  s_waitcnt lgkmcnt(0)
  s_mov_b32 s20, s4
  s_and_b32 s21, s5, 0xffff
  s_mov_b32 s22, 131072
  s_mov_b32 s23, 0x20000
  s_mov_b32 s24, s6
  s_and_b32 s25, s7, 0xffff
  s_mov_b32 s26, 7340032
  s_mov_b32 s27, 0x20000
  s_mov_b32 s28, s8
  s_and_b32 s29, s9, 0xffff
  s_mov_b32 s30, 7340032
  s_mov_b32 s31, 0x20000
  buffer_load_dword v20, v2, s[20:23], s50 offen
  s_mov_b32 exec_hi, 0x00ffffff
p2l_touch0:
  buffer_load_dword v21, v1, s[24:27], s49 offen
  buffer_load_dword v22, v1, s[28:31], s49 offen
  s_add_u32 s49, s49, 917504
  s_add_u32 s53, s53, 1
  s_cmp_lt_u32 s53, 3
  s_cbranch_scc1 p2l_touch0
  s_mov_b32 s64, s14
  s_and_b32 s65, s15, 0xffff
  s_mov_b32 s66, 256
  s_mov_b32 s67, 0x20000
  s_mov_b64 s[74:75], exec
  s_getreg_b32 s68, hwreg(HW_REG_XCC_ID, 0, 4)
  s_or_b32 s68, s68, 0x80
  s_lshl_b32 s69, s47, 5
  s_add_u32 s69, s69, s46
  s_mov_b64 exec, 1
  v_mov_b32 v6, s68
  v_mov_b32 v7, s69
  buffer_store_byte v6, v7, s[64:67], 0 offen sc1
  s_mov_b64 exec, -1
  s_mov_b64 exec, s[74:75]
p2l_touch:
  buffer_load_dword v21, v1, s[24:27], s49 offen
  buffer_load_dword v22, v1, s[28:31], s49 offen
  s_add_u32 s49, s49, 917504
  s_add_u32 s53, s53, 1
  s_cmp_lt_u32 s53, 7
  s_cbranch_scc1 p2l_touch
  s_mov_b32 s32, s10
  s_and_b32 s33, s11, 0xffff
  s_mov_b32 s34, 7340032
  s_mov_b32 s35, 0x20000
  v_lshrrev_b32 v3, 1, v0
  v_lshlrev_b32 v3, 11, v3
  v_and_b32 v4, 1, v0
  v_lshl_add_u32 v3, v4, 10, v3
  s_mul_i32 s50, s47, 448
  s_mul_i32 s51, s45, 28
  s_add_u32 s50, s50, s51
  s_lshl_b32 s50, s50, 11
  s_add_u32 s50, s50, 384
  buffer_load_dword v23, v3, s[32:35], s50 offen
  s_mov_b32 exec_hi, -1
  v_lshrrev_b32 v1, 3, v0
  v_and_b32 v2, 7, v0
  v_bfe_u32 v3, v0, 4, 2
  v_lshlrev_b32 v3, 1, v3
  v_xor_b32 v2, v2, v3
  v_lshlrev_b32 v1, 11, v1
  v_lshl_add_u32 v10, v2, 4, v1
  v_add_u32 v11, 15360, v10
  v_add_u32 v12, 30720, v10
  v_add_u32 v13, 46080, v10
  s_mul_i32 s50, s47, 917504
  s_lshl_b32 s51, s45, 7
  s_add_u32 s50, s50, s51
  s_mov_b32 s32, s10
  s_and_b32 s33, s11, 0xffff
  s_mov_b32 s34, 7340032
  s_mov_b32 s35, 0x20000
  s_mov_b32 s64, s14
  s_and_b32 s65, s15, 0xffff
  s_mov_b32 s66, 256
  s_mov_b32 s67, 0x20000
  s_lshl_b32 s58, s47, 5
  s_add_u32 s58, s58, 12
  v_mul_u32_u24 v2, s58, v0
  s_mov_b32 s52, 0
p2l_wd:
  s_mov_b32 m0, s52
  s_add_u32 s52, s52, 4096
  buffer_load_dwordx4 v10, s[32:35], s50 offen lds
  buffer_load_dwordx4 v11, s[32:35], s50 offen offset:1024 lds
  buffer_load_dwordx4 v12, s[32:35], s50 offen offset:2048 lds
  buffer_load_dwordx4 v13, s[32:35], s50 offen offset:3072 lds
  s_add_u32 s50, s50, 65536
  s_cmp_lt_u32 s52, 57344
  s_cbranch_scc1 p2l_wd
  s_barrier
  s_waitcnt vmcnt(0)
  s_barrier
  s_endpgm
k_p1c:
  s_mul_i32 s44, s47, 7
  s_lshr_b32 s45, s46, 1
  s_add_u32 s44, s44, s45
  s_and_b32 s45, s46, 1
  s_sub_u32 s57, s3, 2
  v_and_b32 v1, 15, v0
  v_lshrrev_b32 v2, 4, v0
  v_lshlrev_b32 v3, 7, v1
  v_lshrrev_b32 v4, 1, v1
  v_xor_b32 v4, v2, v4
  v_lshl_add_u32 v3, v4, 4, v3
  v_add_u32 v10, 16384, v3
  v_xor_b32 v11, 64, v10
  v_bfe_u32 v3, v0, 2, 2
  v_and_b32 v4, 3, v0
  v_lshl_add_u32 v5, v2, 3, v3
  v_lshlrev_b32 v5, 7, v5
  v_lshl_add_u32 v5, v4, 3, v5
  v_lshrrev_b32 v6, 1, v3
  v_and_b32 v7, 1, v2
  v_lshl_add_u32 v6, v7, 1, v6
  v_xor_b32 v7, s57, v6
  v_lshl_add_u32 v12, v7, 5, v5
  v_mov_b32 v14, v10
  v_mov_b32 v15, v11
  v_mov_b32 v16, v12
  v_mov_b32 v24, 0
  v_mov_b32 v25, 0
  v_mov_b32 v26, 0
  v_mov_b32 v27, 0
  v_mov_b32 v28, 0
  v_mov_b32 v29, 0
  v_mov_b32 v30, 0
  v_mov_b32 v31, 0
  v_mov_b32 v32, 0
  v_mov_b32 v33, 0
  v_mov_b32 v34, 0
  v_mov_b32 v35, 0
  v_mov_b32 v36, 0
  v_mov_b32 v37, 0
  v_mov_b32 v38, 0
  v_mov_b32 v39, 0
  v_mov_b32 v72, 0
  v_mov_b32 v73, 0
  v_mov_b32 v74, 0
  v_mov_b32 v75, 0
  v_mov_b32 v76, 0
  v_mov_b32 v77, 0
  v_mov_b32 v78, 0
  v_mov_b32 v79, 0
  v_mov_b32 v80, 0
  v_mov_b32 v81, 0
  v_mov_b32 v82, 0
  v_mov_b32 v83, 0
  v_mov_b32 v84, 0
  v_mov_b32 v85, 0
  v_mov_b32 v86, 0
  v_mov_b32 v87, 0
  v_mov_b32 v88, 0
  v_mov_b32 v89, 0
  v_mov_b32 v90, 0
  v_mov_b32 v91, 0
  v_mov_b32 v92, 0
  v_mov_b32 v93, 0
  v_mov_b32 v94, 0
  v_mov_b32 v95, 0
  v_mov_b32 v96, 0
  v_mov_b32 v97, 0
  v_mov_b32 v98, 0
  v_mov_b32 v99, 0
  v_mov_b32 v100, 0
  v_mov_b32 v101, 0
  v_mov_b32 v102, 0
  v_mov_b32 v103, 0
  s_mul_i32 s61, s45, 224
  s_lshl_b32 s62, s44, 1
  s_add_u32 s61, s61, s62
  s_lshr_b32 s62, s57, 1
  s_add_u32 s61, s61, s62
  s_lshl_b32 s61, s61, 10
  s_add_u32 s62, s61, 114688
  s_and_b32 s58, s57, 1
  s_lshl_b32 s58, s58, 3
  v_lshlrev_b32 v23, 4, v0
  v_add_u32 v23, s58, v23
  s_mov_b32 s52, 0
  s_mov_b32 s53, 0
  s_getreg_b32 s68, hwreg(HW_REG_XCC_ID, 0, 4)
  s_or_b32 s68, s68, 0x80
  s_mul_i32 s63, s68, 0x01010101
  s_waitcnt lgkmcnt(0)
  s_mov_b32 s36, s16
  s_and_b32 s37, s17, 0xffff
  s_mov_b32 s38, 4194304
  s_mov_b32 s39, 0x20000
  s_lshl_b32 s58, s47, 5
  s_add_u32 s14, s14, s58
  s_addc_u32 s15, s15, 0
p1c_loop:
  s_barrier
  v_mfma_f32_16x16x32_bf16 v[24:27], v[88:91], v[72:75], v[24:27]
  ds_read_b64_tr_b16 v[56:57], v16 offset:0
  v_mfma_f32_16x16x32_bf16 v[28:31], v[88:91], v[76:79], v[28:31]
  ds_read_b64_tr_b16 v[58:59], v16 offset:512
  ds_read_b64_tr_b16 v[60:61], v16 offset:8192
  v_mfma_f32_16x16x32_bf16 v[32:35], v[92:95], v[72:75], v[32:35]
  ds_read_b64_tr_b16 v[62:63], v16 offset:8704
  v_mfma_f32_16x16x32_bf16 v[36:39], v[92:95], v[76:79], v[36:39]
  ds_read_b128 v[40:43], v14
  ds_read_b128 v[44:47], v14 offset:2048
  v_mfma_f32_16x16x32_bf16 v[24:27], v[96:99], v[80:83], v[24:27]
  ds_read_b64_tr_b16 v[64:65], v16 offset:4096
  v_mfma_f32_16x16x32_bf16 v[28:31], v[96:99], v[84:87], v[28:31]
  ds_read_b64_tr_b16 v[66:67], v16 offset:4608
  ds_read_b64_tr_b16 v[68:69], v16 offset:12288
  v_mfma_f32_16x16x32_bf16 v[32:35], v[100:103], v[80:83], v[32:35]
  ds_read_b64_tr_b16 v[70:71], v16 offset:12800
  v_mfma_f32_16x16x32_bf16 v[36:39], v[100:103], v[84:87], v[36:39]
  ds_read_b128 v[48:51], v15
  ds_read_b128 v[52:55], v15 offset:2048
  s_add_u32 s52, s52, 20480
  s_cmp_eq_u32 s52, 81920
  s_cselect_b32 s52, 0, s52
  v_add_u32 v14, s52, v10
  v_add_u32 v15, s52, v11
  v_add_u32 v16, s52, v12
  s_waitcnt lgkmcnt(0)
  s_barrier
  v_mfma_f32_16x16x32_bf16 v[24:27], v[56:59], v[40:43], v[24:27]
  ds_read_b64_tr_b16 v[88:89], v16 offset:0
  v_mfma_f32_16x16x32_bf16 v[28:31], v[56:59], v[44:47], v[28:31]
  ds_read_b64_tr_b16 v[90:91], v16 offset:512
  ds_read_b64_tr_b16 v[92:93], v16 offset:8192
  v_mfma_f32_16x16x32_bf16 v[32:35], v[60:63], v[40:43], v[32:35]
  ds_read_b64_tr_b16 v[94:95], v16 offset:8704
  v_mfma_f32_16x16x32_bf16 v[36:39], v[60:63], v[44:47], v[36:39]
  ds_read_b128 v[72:75], v14
  ds_read_b128 v[76:79], v14 offset:2048
  v_mfma_f32_16x16x32_bf16 v[24:27], v[64:67], v[48:51], v[24:27]
  ds_read_b64_tr_b16 v[96:97], v16 offset:4096
  v_mfma_f32_16x16x32_bf16 v[28:31], v[64:67], v[52:55], v[28:31]
  ds_read_b64_tr_b16 v[98:99], v16 offset:4608
  ds_read_b64_tr_b16 v[100:101], v16 offset:12288
  v_mfma_f32_16x16x32_bf16 v[32:35], v[68:71], v[48:51], v[32:35]
  ds_read_b64_tr_b16 v[102:103], v16 offset:12800
  v_mfma_f32_16x16x32_bf16 v[36:39], v[68:71], v[52:55], v[36:39]
  ds_read_b128 v[80:83], v15
  ds_read_b128 v[84:87], v15 offset:2048
  s_add_u32 s52, s52, 20480
  s_cmp_eq_u32 s52, 81920
  s_cselect_b32 s52, 0, s52
  v_add_u32 v14, s52, v10
  v_add_u32 v15, s52, v11
  v_add_u32 v16, s52, v12
  s_add_u32 s53, s53, 1
  s_cmp_lt_u32 s53, 8
  s_waitcnt lgkmcnt(0)
  s_cbranch_scc1 p1c_loop
  s_load_dwordx8 s[80:87], s[14:15], 0
  v_mfma_f32_16x16x32_bf16 v[24:27], v[88:91], v[72:75], v[24:27]
  v_mfma_f32_16x16x32_bf16 v[28:31], v[88:91], v[76:79], v[28:31]
  v_mfma_f32_16x16x32_bf16 v[32:35], v[92:95], v[72:75], v[32:35]
  v_mfma_f32_16x16x32_bf16 v[36:39], v[92:95], v[76:79], v[36:39]
  v_mfma_f32_16x16x32_bf16 v[24:27], v[96:99], v[80:83], v[24:27]
  v_mfma_f32_16x16x32_bf16 v[28:31], v[96:99], v[84:87], v[28:31]
  v_mfma_f32_16x16x32_bf16 v[32:35], v[100:103], v[80:83], v[32:35]
  v_mfma_f32_16x16x32_bf16 v[36:39], v[100:103], v[84:87], v[36:39]
  s_mov_b32 s60, 0xffff0000
  s_nop 7
  s_mov_b32 s64, 0xbfb8aa3b
  s_mov_b32 s65, 0xbfb8aa3b
  v_cvt_pk_bf16_f32 v56, v24, v25
  v_cvt_pk_bf16_f32 v57, v26, v27
  v_cvt_pk_bf16_f32 v58, v28, v29
  v_cvt_pk_bf16_f32 v59, v30, v31
  v_lshlrev_b32 v40, 16, v56
  v_and_b32 v41, s60, v56
  v_lshlrev_b32 v42, 16, v57
  v_and_b32 v43, s60, v57
  v_lshlrev_b32 v44, 16, v58
  v_and_b32 v45, s60, v58
  v_lshlrev_b32 v46, 16, v59
  v_and_b32 v47, s60, v59
  v_pk_mul_f32 v[40:41], v[40:41], s[64:65]
  v_pk_mul_f32 v[42:43], v[42:43], s[64:65]
  v_pk_mul_f32 v[44:45], v[44:45], s[64:65]
  v_pk_mul_f32 v[46:47], v[46:47], s[64:65]
  v_exp_f32 v40, v40
  v_exp_f32 v41, v41
  v_cvt_pk_bf16_f32 v60, v32, v33
  v_exp_f32 v42, v42
  v_exp_f32 v43, v43
  v_cvt_pk_bf16_f32 v61, v34, v35
  v_exp_f32 v44, v44
  v_exp_f32 v45, v45
  v_cvt_pk_bf16_f32 v62, v36, v37
  v_exp_f32 v46, v46
  v_exp_f32 v47, v47
  v_cvt_pk_bf16_f32 v63, v38, v39
  v_add_f32 v40, 1.0, v40
  v_add_f32 v41, 1.0, v41
  v_add_f32 v42, 1.0, v42
  v_add_f32 v43, 1.0, v43
  v_add_f32 v44, 1.0, v44
  v_add_f32 v45, 1.0, v45
  v_add_f32 v46, 1.0, v46
  v_add_f32 v47, 1.0, v47
  v_rcp_f32 v40, v40
  v_rcp_f32 v41, v41
  v_lshlrev_b32 v48, 16, v60
  v_and_b32 v49, s60, v60
  v_rcp_f32 v42, v42
  v_rcp_f32 v43, v43
  v_lshlrev_b32 v50, 16, v61
  v_and_b32 v51, s60, v61
  v_rcp_f32 v44, v44
  v_rcp_f32 v45, v45
  v_lshlrev_b32 v52, 16, v62
  v_and_b32 v53, s60, v62
  v_rcp_f32 v46, v46
  v_rcp_f32 v47, v47
  v_lshlrev_b32 v54, 16, v63
  v_and_b32 v55, s60, v63
  v_cvt_pk_bf16_f32 v56, v40, v41
  v_cvt_pk_bf16_f32 v57, v42, v43
  v_cvt_pk_bf16_f32 v58, v44, v45
  v_cvt_pk_bf16_f32 v59, v46, v47
  v_lshlrev_b32 v40, 16, v56
  v_and_b32 v41, s60, v56
  v_lshlrev_b32 v42, 16, v57
  v_and_b32 v43, s60, v57
  v_lshlrev_b32 v44, 16, v58
  v_and_b32 v45, s60, v58
  v_lshlrev_b32 v46, 16, v59
  v_and_b32 v47, s60, v59
  v_pk_mul_f32 v[40:41], v[40:41], v[48:49]
  v_pk_mul_f32 v[42:43], v[42:43], v[50:51]
  v_pk_mul_f32 v[44:45], v[44:45], v[52:53]
  v_pk_mul_f32 v[46:47], v[46:47], v[54:55]
  v_cvt_pk_bf16_f32 v18, v40, v41
  v_cvt_pk_bf16_f32 v19, v42, v43
  v_cvt_pk_bf16_f32 v20, v44, v45
  v_cvt_pk_bf16_f32 v21, v46, v47
  v_min_u32 v18, -2, v18
  v_min_u32 v19, -2, v19
  v_min_u32 v20, -2, v20
  v_min_u32 v21, -2, v21
  s_waitcnt lgkmcnt(0)
  s_and_b32 s83, s83, 0x80800000
  s_cmp_eq_u32 s83, 0x80800000
  s_cbranch_scc1 p1c_hs_ok
  s_mov_b32 s64, s14
  s_and_b32 s65, s15, 0xffff
  s_mov_b32 s66, 32
  s_mov_b32 s67, 0x20000
  v_and_b32 v1, 7, v0
  v_lshlrev_b32 v1, 2, v1
  s_mov_b32 s59, 0
p1c_hs:
  buffer_load_dword v2, v1, s[64:67], 0 offen sc1
  s_add_u32 s59, s59, 1
  s_waitcnt vmcnt(0)
  v_readlane_b32 s83, v2, 3
  v_readlane_b32 s84, v2, 4
  v_readlane_b32 s85, v2, 5
  v_readlane_b32 s86, v2, 6
  v_readlane_b32 s87, v2, 7
  s_cmp_ge_u32 s59, 40000
  s_cbranch_scc1 p1c_hs_ok
  s_and_b32 s83, s83, 0x80800000
  s_cmp_eq_u32 s83, 0x80800000
  s_cbranch_scc0 p1c_hs
p1c_hs_ok:
  s_xor_b32 s84, s84, s63
  s_xor_b32 s85, s85, s63
  s_xor_b32 s86, s86, s63
  s_xor_b32 s87, s87, s63
  s_or_b32 s84, s84, s85
  s_or_b32 s86, s86, s87
  s_or_b32 s84, s84, s86
  s_cbranch_scc1 p1c_st_global
  buffer_store_dwordx2 v[18:19], v23, s[36:39], s61 offen
  buffer_store_dwordx2 v[20:21], v23, s[36:39], s62 offen
  s_branch p1c_st_done
p1c_st_global:
  buffer_store_dwordx2 v[18:19], v23, s[36:39], s61 offen sc1
  buffer_store_dwordx2 v[20:21], v23, s[36:39], s62 offen sc1
p1c_st_done:
  s_endpgm
k_xh0:
  s_memrealtime s[90:91]
  s_waitcnt lgkmcnt(0)
  s_mov_b32 s64, s14
  s_and_b32 s65, s15, 0xffff
  s_mov_b32 s66, 256
  s_mov_b32 s67, 0x20000
  s_or_b32 s90, s90, 1
  s_lshl_b32 s48, s47, 5
  s_add_u32 s48, s48, s46
  s_cmp_eq_u32 s48, 14
  s_cbranch_scc0 xh_a
  s_mov_b64 exec, 1
  v_mov_b32 v2, s90
  v_mov_b32 v3, 0
  buffer_store_dword v2, v3, s[64:67], 0 offen sc1
  s_mov_b64 exec, -1
xh_a:
  s_barrier
  s_getreg_b32 s68, hwreg(HW_REG_XCC_ID, 0, 4)
  s_or_b32 s68, s68, 0x80
  s_lshl_b32 s69, s47, 5
  s_add_u32 s69, s69, s46
  s_mov_b64 exec, 1
  v_mov_b32 v2, s68
  v_mov_b32 v3, s69
  buffer_store_byte v2, v3, s[64:67], 0 offen sc1
  s_mov_b64 exec, -1
  s_endpgm
xh_w:
  v_lshlrev_b32 v1, 4, v0
  v_mov_b32 v4, -1
  v_mov_b32 v5, -1
  v_mov_b32 v6, -1
  v_mov_b32 v7, -1
  s_sub_u32 s51, s3, 2
  s_sub_u32 s48, s46, 14
  s_lshl_b32 s49, s48, 1
  s_lshr_b32 s50, s51, 1
  s_add_u32 s49, s49, s50
  s_mul_i32 s49, s49, 112
  s_mul_i32 s50, s47, 14
  s_add_u32 s49, s49, s50
  s_and_b32 s50, s51, 1
  s_mul_i32 s50, s50, 7
  s_add_u32 s49, s49, s50
  s_lshl_b32 s49, s49, 10
  s_add_u32 s50, s49, 4096
  v_lshlrev_b32 v2, 7, v0
  s_waitcnt lgkmcnt(0)
  s_mov_b32 s36, s16
  s_and_b32 s37, s17, 0xffff
  s_mov_b32 s38, 4194304
  s_mov_b32 s39, 0x20000
  buffer_store_dwordx4 v[4:7], v1, s[36:39], s49 offen sc1
  buffer_store_dwordx4 v[4:7], v1, s[36:39], s49 offen offset:1024 sc1
  buffer_store_dwordx4 v[4:7], v1, s[36:39], s49 offen offset:2048 sc1
  buffer_store_dwordx4 v[4:7], v1, s[36:39], s49 offen offset:3072 sc1
  buffer_store_dwordx4 v[4:7], v1, s[36:39], s50 offen sc1
  buffer_store_dwordx4 v[4:7], v1, s[36:39], s50 offen offset:1024 sc1
  buffer_store_dwordx4 v[4:7], v1, s[36:39], s50 offen offset:2048 sc1
  s_waitcnt vmcnt(0)
  s_mov_b32 exec_hi, 0x00ffffff
  buffer_load_dword v8, v2, s[36:39], s49 offen sc1
  s_waitcnt vmcnt(0)
  s_barrier
  s_endpgm
k_p2c:
  s_sub_u32 s44, s3, 2
  s_cmp_eq_u32 s44, 0
  s_cbranch_scc0 p2c_a
p2c_a:
  v_lshrrev_b32 v2, 4, v0
  v_bfe_u32 v3, v0, 2, 2
  v_and_b32 v4, 3, v0
  v_lshl_add_u32 v5, v2, 2, v3
  v_lshrrev_b32 v6, 1, v5
  v_and_b32 v6, 3, v6
  v_lshlrev_b32 v5, 7, v5
  v_lshl_add_u32 v5, v4, 3, v5
  s_and_b32 s52, s47, 1
  s_lshl_b32 s53, s52, 1
  v_xor_b32 v6, s53, v6
  v_xor_b32 v1, 0, v6
  v_lshl_add_u32 v12, v1, 5, v5
  v_xor_b32 v1, 1, v6
  v_lshl_add_u32 v13, v1, 5, v5
  v_xor_b32 v1, 2, v6
  v_lshl_add_u32 v14, v1, 5, v5
  v_xor_b32 v1, 3, v6
  v_lshl_add_u32 v15, v1, 5, v5
  s_mul_i32 s54, s44, 112
  s_mul_i32 s55, s47, 14
  s_add_u32 s54, s54, s55
  s_lshl_b32 s54, s54, 10
  s_add_u32 s48, s54, 4096
  s_add_u32 s49, s54, 8192
  s_add_u32 s50, s54, 12288
  v_lshlrev_b32 v11, 4, v0
  v_lshlrev_b32 v32, 11, v0
  v_cmp_gt_u32 vcc, 7, v0
  v_mov_b32 v1, 0x7ffffff0
  v_mov_b32 v9, 57344
  v_cndmask_b32 v32, v1, v32, vcc
  s_lshl_b32 s55, s45, 3
  s_lshl_b32 s56, s44, 1
  s_add_u32 s56, s56, s52
  s_add_u32 s57, s55, s56
  s_lshl_b32 s57, s57, 3
  s_add_u32 s57, s57, s47
  s_lshl_b32 s57, s57, 11
  s_add_u32 s57, s57, 524288
  s_xor_b32 s56, s56, 1
  s_add_u32 s53, s55, s56
  s_lshl_b32 s53, s53, 3
  s_add_u32 s53, s53, s47
  s_lshl_b32 s53, s53, 11
  s_add_u32 s53, s53, 524288
  s_add_u32 s58, s55, s47
  s_lshl_b32 s58, s58, 14
  s_add_u32 s58, s58, 524288
  s_add_u32 s60, s47, 1
  s_and_b32 s60, s60, 7
  s_lshl_b32 s60, s60, 11
  s_add_u32 s73, s58, s60
  s_add_u32 s60, s47, 2
  s_and_b32 s60, s60, 7
  s_lshl_b32 s60, s60, 11
  s_add_u32 s74, s58, s60
  s_add_u32 s60, s47, 3
  s_and_b32 s60, s60, 7
  s_lshl_b32 s60, s60, 11
  s_add_u32 s75, s58, s60
  s_add_u32 s60, s47, 4
  s_and_b32 s60, s60, 7
  s_lshl_b32 s60, s60, 11
  s_add_u32 s76, s58, s60
  s_add_u32 s60, s47, 5
  s_and_b32 s60, s60, 7
  s_lshl_b32 s60, s60, 11
  s_add_u32 s77, s58, s60
  s_add_u32 s60, s47, 6
  s_and_b32 s60, s60, 7
  s_lshl_b32 s60, s60, 11
  s_add_u32 s78, s58, s60
  s_add_u32 s60, s47, 7
  s_and_b32 s60, s60, 7
  s_lshl_b32 s60, s60, 11
  s_add_u32 s79, s58, s60
  v_and_b32 v2, 15, v0
  s_lshl_b32 s60, s44, 4
  v_add_u32 v2, s60, v2
  v_lshlrev_b32 v2, 11, v2
  v_lshrrev_b32 v3, 4, v0
  v_lshl_add_u32 v10, v3, 3, v2
  s_lshl_b32 s61, s45, 7
  s_lshl_b32 s62, s52, 6
  s_add_u32 s61, s61, s62
  s_waitcnt lgkmcnt(0)
  s_mov_b32 s36, s16
  s_and_b32 s37, s17, 0xffff
  s_mov_b32 s38, 4194304
  s_mov_b32 s39, 0x20000
  s_mov_b32 s40, s12
  s_and_b32 s41, s13, 0xffff
  s_mov_b32 s42, 131072
  s_mov_b32 s43, 0x20000
  s_barrier
  s_lshl_b32 s62, s47, 5
  s_add_u32 s62, s62, 12
  s_load_dword s63, s[14:15], s62
  s_load_dword s90, s[14:15], 0
  s_mov_b32 s59, 0
  s_waitcnt lgkmcnt(0)
p2c_hs:
  s_and_b32 s63, s63, 0x80800000
  s_and_b32 s60, s90, 1
  s_or_b32 s63, s63, s60
  s_cmp_eq_u32 s63, 0x80800001
  s_cbranch_scc1 p2c_hs_ok
  s_add_u32 s59, s59, 1
  s_cmp_ge_u32 s59, 40000
  s_cbranch_scc1 p2c_hs_ok
  s_mov_b32 s64, s14
  s_and_b32 s65, s15, 0xffff
  s_mov_b32 s66, 256
  s_mov_b32 s67, 0x20000
  v_mul_u32_u24 v2, s62, v0
  buffer_load_dword v1, v2, s[64:67], 0 offen sc1
  s_waitcnt vmcnt(0)
  v_readlane_b32 s90, v1, 0
  v_readlane_b32 s63, v1, 1
  s_nop 0
  s_branch p2c_hs
p2c_hs_ok:
  v_mov_b32 v8, s90
  s_mov_b32 s59, 0
  buffer_load_dword v34, v32, s[36:39], s54 offen sc1
  v_and_b32 v1, 1, v0
  v_lshlrev_b32 v1, 4, v1
  s_waitcnt lgkmcnt(0)
  v_lshrrev_b32 v2, v1, v8
  v_lshrrev_b32 v3, 8, v2
  v_and_b32 v35, 0xff, v2
  v_and_b32 v36, 0xff, v3
  s_barrier
  s_waitcnt vmcnt(0)
  v_cmp_eq_u32 vcc, -1, v34
  s_cbranch_vccz p2c_sent_ok
p2c_retry:
p2c_sent:
  buffer_load_dword v34, v32, s[36:39], s54 offen sc1
  s_add_u32 s59, s59, 1
  s_cmp_ge_u32 s59, 40000
  s_cbranch_scc1 p2c_sent_ok
  s_waitcnt vmcnt(0)
  v_cmp_eq_u32 vcc, -1, v34
  s_cbranch_vccnz p2c_sent
p2c_sent_ok:
  buffer_load_dwordx4 v[40:43], v11, s[36:39], s54 offen sc1
  ds_read_b64_tr_b16 v[100:101], v12 offset:0
  ds_read_b64_tr_b16 v[102:103], v12 offset:2048
  ds_read_b64_tr_b16 v[104:105], v13 offset:0
  buffer_load_dwordx4 v[44:47], v11, s[36:39], s54 offen offset:1024 sc1
  ds_read_b64_tr_b16 v[106:107], v13 offset:2048
  ds_read_b64_tr_b16 v[108:109], v14 offset:0
  ds_read_b64_tr_b16 v[110:111], v14 offset:2048
  buffer_load_dwordx4 v[48:51], v11, s[36:39], s54 offen offset:2048 sc1
  ds_read_b64_tr_b16 v[112:113], v15 offset:0
  ds_read_b64_tr_b16 v[114:115], v15 offset:2048
  ds_read_b64_tr_b16 v[116:117], v12 offset:4096
  buffer_load_dwordx4 v[52:55], v11, s[36:39], s54 offen offset:3072 sc1
  ds_read_b64_tr_b16 v[118:119], v12 offset:6144
  ds_read_b64_tr_b16 v[120:121], v13 offset:4096
  ds_read_b64_tr_b16 v[122:123], v13 offset:6144
  buffer_load_dwordx4 v[56:59], v11, s[36:39], s48 offen sc1
  ds_read_b64_tr_b16 v[124:125], v14 offset:4096
  ds_read_b64_tr_b16 v[126:127], v14 offset:6144
  ds_read_b64_tr_b16 v[128:129], v15 offset:4096
  ds_read_b64_tr_b16 v[130:131], v15 offset:6144
  v_mov_b32 v33, 0
  buffer_load_dwordx4 v[60:63], v11, s[36:39], s48 offen offset:1024 sc1
  s_waitcnt vmcnt(5) lgkmcnt(8)
  v_max3_u32 v33, v33, v40, v41
  v_max3_u32 v33, v33, v42, v43
  v_mfma_f32_16x16x32_bf16 v[16:19], v[100:103], v[40:43], 0
  ds_read_b64_tr_b16 v[132:133], v12 offset:8192
  ds_read_b64_tr_b16 v[134:135], v12 offset:10240
  v_mfma_f32_16x16x32_bf16 v[20:23], v[104:107], v[40:43], 0
  ds_read_b64_tr_b16 v[136:137], v13 offset:8192
  ds_read_b64_tr_b16 v[138:139], v13 offset:10240
  v_mfma_f32_16x16x32_bf16 v[24:27], v[108:111], v[40:43], 0
  ds_read_b64_tr_b16 v[140:141], v14 offset:8192
  ds_read_b64_tr_b16 v[142:143], v14 offset:10240
  v_mfma_f32_16x16x32_bf16 v[28:31], v[112:115], v[40:43], 0
  ds_read_b64_tr_b16 v[144:145], v15 offset:8192
  ds_read_b64_tr_b16 v[146:147], v15 offset:10240
  buffer_load_dwordx4 v[64:67], v11, s[36:39], s48 offen offset:2048 sc1
  s_waitcnt vmcnt(5) lgkmcnt(8)
  v_max3_u32 v33, v33, v44, v45
  v_max3_u32 v33, v33, v46, v47
  v_mfma_f32_16x16x32_bf16 v[16:19], v[116:119], v[44:47], v[16:19]
  ds_read_b64_tr_b16 v[100:101], v12 offset:12288
  ds_read_b64_tr_b16 v[102:103], v12 offset:14336
  v_mfma_f32_16x16x32_bf16 v[20:23], v[120:123], v[44:47], v[20:23]
  ds_read_b64_tr_b16 v[104:105], v13 offset:12288
  ds_read_b64_tr_b16 v[106:107], v13 offset:14336
  v_mfma_f32_16x16x32_bf16 v[24:27], v[124:127], v[44:47], v[24:27]
  ds_read_b64_tr_b16 v[108:109], v14 offset:12288
  ds_read_b64_tr_b16 v[110:111], v14 offset:14336
  v_mfma_f32_16x16x32_bf16 v[28:31], v[128:131], v[44:47], v[28:31]
  ds_read_b64_tr_b16 v[112:113], v15 offset:12288
  ds_read_b64_tr_b16 v[114:115], v15 offset:14336
  buffer_load_dwordx4 v[68:71], v11, s[36:39], s48 offen offset:3072 sc1
  s_waitcnt vmcnt(5) lgkmcnt(8)
  v_max3_u32 v33, v33, v48, v49
  v_max3_u32 v33, v33, v50, v51
  v_mfma_f32_16x16x32_bf16 v[16:19], v[132:135], v[48:51], v[16:19]
  ds_read_b64_tr_b16 v[116:117], v12 offset:16384
  ds_read_b64_tr_b16 v[118:119], v12 offset:18432
  v_mfma_f32_16x16x32_bf16 v[20:23], v[136:139], v[48:51], v[20:23]
  ds_read_b64_tr_b16 v[120:121], v13 offset:16384
  ds_read_b64_tr_b16 v[122:123], v13 offset:18432
  v_mfma_f32_16x16x32_bf16 v[24:27], v[140:143], v[48:51], v[24:27]
  ds_read_b64_tr_b16 v[124:125], v14 offset:16384
  ds_read_b64_tr_b16 v[126:127], v14 offset:18432
  v_mfma_f32_16x16x32_bf16 v[28:31], v[144:147], v[48:51], v[28:31]
  ds_read_b64_tr_b16 v[128:129], v15 offset:16384
  ds_read_b64_tr_b16 v[130:131], v15 offset:18432
  buffer_load_dwordx4 v[72:75], v11, s[36:39], s49 offen sc1
  s_waitcnt vmcnt(5) lgkmcnt(8)
  v_max3_u32 v33, v33, v52, v53
  v_max3_u32 v33, v33, v54, v55
  v_mfma_f32_16x16x32_bf16 v[16:19], v[100:103], v[52:55], v[16:19]
  ds_read_b64_tr_b16 v[132:133], v12 offset:20480
  ds_read_b64_tr_b16 v[134:135], v12 offset:22528
  v_mfma_f32_16x16x32_bf16 v[20:23], v[104:107], v[52:55], v[20:23]
  ds_read_b64_tr_b16 v[136:137], v13 offset:20480
  ds_read_b64_tr_b16 v[138:139], v13 offset:22528
  v_mfma_f32_16x16x32_bf16 v[24:27], v[108:111], v[52:55], v[24:27]
  ds_read_b64_tr_b16 v[140:141], v14 offset:20480
  ds_read_b64_tr_b16 v[142:143], v14 offset:22528
  v_mfma_f32_16x16x32_bf16 v[28:31], v[112:115], v[52:55], v[28:31]
  ds_read_b64_tr_b16 v[144:145], v15 offset:20480
  ds_read_b64_tr_b16 v[146:147], v15 offset:22528
  buffer_load_dwordx4 v[76:79], v11, s[36:39], s49 offen offset:1024 sc1
  s_waitcnt vmcnt(5) lgkmcnt(8)
  v_max3_u32 v33, v33, v56, v57
  v_max3_u32 v33, v33, v58, v59
  v_mfma_f32_16x16x32_bf16 v[16:19], v[116:119], v[56:59], v[16:19]
  ds_read_b64_tr_b16 v[100:101], v12 offset:24576
  ds_read_b64_tr_b16 v[102:103], v12 offset:26624
  v_mfma_f32_16x16x32_bf16 v[20:23], v[120:123], v[56:59], v[20:23]
  ds_read_b64_tr_b16 v[104:105], v13 offset:24576
  ds_read_b64_tr_b16 v[106:107], v13 offset:26624
  v_mfma_f32_16x16x32_bf16 v[24:27], v[124:127], v[56:59], v[24:27]
  ds_read_b64_tr_b16 v[108:109], v14 offset:24576
  ds_read_b64_tr_b16 v[110:111], v14 offset:26624
  v_mfma_f32_16x16x32_bf16 v[28:31], v[128:131], v[56:59], v[28:31]
  ds_read_b64_tr_b16 v[112:113], v15 offset:24576
  ds_read_b64_tr_b16 v[114:115], v15 offset:26624
  buffer_load_dwordx4 v[80:83], v11, s[36:39], s49 offen offset:2048 sc1
  s_waitcnt vmcnt(5) lgkmcnt(8)
  v_max3_u32 v33, v33, v60, v61
  v_max3_u32 v33, v33, v62, v63
  v_mfma_f32_16x16x32_bf16 v[16:19], v[132:135], v[60:63], v[16:19]
  ds_read_b64_tr_b16 v[116:117], v12 offset:28672
  ds_read_b64_tr_b16 v[118:119], v12 offset:30720
  v_mfma_f32_16x16x32_bf16 v[20:23], v[136:139], v[60:63], v[20:23]
  ds_read_b64_tr_b16 v[120:121], v13 offset:28672
  ds_read_b64_tr_b16 v[122:123], v13 offset:30720
  v_mfma_f32_16x16x32_bf16 v[24:27], v[140:143], v[60:63], v[24:27]
  ds_read_b64_tr_b16 v[124:125], v14 offset:28672
  ds_read_b64_tr_b16 v[126:127], v14 offset:30720
  v_mfma_f32_16x16x32_bf16 v[28:31], v[144:147], v[60:63], v[28:31]
  ds_read_b64_tr_b16 v[128:129], v15 offset:28672
  ds_read_b64_tr_b16 v[130:131], v15 offset:30720
  buffer_load_dwordx4 v[84:87], v11, s[36:39], s49 offen offset:3072 sc1
  s_waitcnt vmcnt(5) lgkmcnt(8)
  v_max3_u32 v33, v33, v64, v65
  v_max3_u32 v33, v33, v66, v67
  v_mfma_f32_16x16x32_bf16 v[16:19], v[100:103], v[64:67], v[16:19]
  ds_read_b64_tr_b16 v[132:133], v12 offset:32768
  ds_read_b64_tr_b16 v[134:135], v12 offset:34816
  v_mfma_f32_16x16x32_bf16 v[20:23], v[104:107], v[64:67], v[20:23]
  ds_read_b64_tr_b16 v[136:137], v13 offset:32768
  ds_read_b64_tr_b16 v[138:139], v13 offset:34816
  v_mfma_f32_16x16x32_bf16 v[24:27], v[108:111], v[64:67], v[24:27]
  ds_read_b64_tr_b16 v[140:141], v14 offset:32768
  ds_read_b64_tr_b16 v[142:143], v14 offset:34816
  v_mfma_f32_16x16x32_bf16 v[28:31], v[112:115], v[64:67], v[28:31]
  ds_read_b64_tr_b16 v[144:145], v15 offset:32768
  ds_read_b64_tr_b16 v[146:147], v15 offset:34816
  buffer_load_dwordx4 v[88:91], v11, s[36:39], s50 offen sc1
  s_waitcnt vmcnt(5) lgkmcnt(8)
  v_max3_u32 v33, v33, v68, v69
  v_max3_u32 v33, v33, v70, v71
  v_mfma_f32_16x16x32_bf16 v[16:19], v[116:119], v[68:71], v[16:19]
  ds_read_b64_tr_b16 v[100:101], v12 offset:36864
  ds_read_b64_tr_b16 v[102:103], v12 offset:38912
  v_mfma_f32_16x16x32_bf16 v[20:23], v[120:123], v[68:71], v[20:23]
  ds_read_b64_tr_b16 v[104:105], v13 offset:36864
  ds_read_b64_tr_b16 v[106:107], v13 offset:38912
  v_mfma_f32_16x16x32_bf16 v[24:27], v[124:127], v[68:71], v[24:27]
  ds_read_b64_tr_b16 v[108:109], v14 offset:36864
  ds_read_b64_tr_b16 v[110:111], v14 offset:38912
  v_mfma_f32_16x16x32_bf16 v[28:31], v[128:131], v[68:71], v[28:31]
  ds_read_b64_tr_b16 v[112:113], v15 offset:36864
  ds_read_b64_tr_b16 v[114:115], v15 offset:38912
  buffer_load_dwordx4 v[92:95], v11, s[36:39], s50 offen offset:1024 sc1
  s_waitcnt vmcnt(5) lgkmcnt(8)
  v_max3_u32 v33, v33, v72, v73
  v_max3_u32 v33, v33, v74, v75
  v_mfma_f32_16x16x32_bf16 v[16:19], v[132:135], v[72:75], v[16:19]
  ds_read_b64_tr_b16 v[116:117], v12 offset:40960
  ds_read_b64_tr_b16 v[118:119], v12 offset:43008
  v_mfma_f32_16x16x32_bf16 v[20:23], v[136:139], v[72:75], v[20:23]
  ds_read_b64_tr_b16 v[120:121], v13 offset:40960
  ds_read_b64_tr_b16 v[122:123], v13 offset:43008
  v_mfma_f32_16x16x32_bf16 v[24:27], v[140:143], v[72:75], v[24:27]
  ds_read_b64_tr_b16 v[124:125], v14 offset:40960
  ds_read_b64_tr_b16 v[126:127], v14 offset:43008
  v_mfma_f32_16x16x32_bf16 v[28:31], v[144:147], v[72:75], v[28:31]
  ds_read_b64_tr_b16 v[128:129], v15 offset:40960
  ds_read_b64_tr_b16 v[130:131], v15 offset:43008
  s_waitcnt vmcnt(4) lgkmcnt(8)
  v_max3_u32 v33, v33, v76, v77
  v_max3_u32 v33, v33, v78, v79
  v_mfma_f32_16x16x32_bf16 v[16:19], v[100:103], v[76:79], v[16:19]
  ds_read_b64_tr_b16 v[132:133], v12 offset:45056
  ds_read_b64_tr_b16 v[134:135], v12 offset:47104
  v_mfma_f32_16x16x32_bf16 v[20:23], v[104:107], v[76:79], v[20:23]
  ds_read_b64_tr_b16 v[136:137], v13 offset:45056
  ds_read_b64_tr_b16 v[138:139], v13 offset:47104
  v_mfma_f32_16x16x32_bf16 v[24:27], v[108:111], v[76:79], v[24:27]
  ds_read_b64_tr_b16 v[140:141], v14 offset:45056
  ds_read_b64_tr_b16 v[142:143], v14 offset:47104
  v_mfma_f32_16x16x32_bf16 v[28:31], v[112:115], v[76:79], v[28:31]
  ds_read_b64_tr_b16 v[144:145], v15 offset:45056
  ds_read_b64_tr_b16 v[146:147], v15 offset:47104
  s_waitcnt vmcnt(3) lgkmcnt(8)
  v_max3_u32 v33, v33, v80, v81
  v_max3_u32 v33, v33, v82, v83
  v_mfma_f32_16x16x32_bf16 v[16:19], v[116:119], v[80:83], v[16:19]
  ds_read_b64_tr_b16 v[100:101], v12 offset:49152
  ds_read_b64_tr_b16 v[102:103], v12 offset:51200
  v_mfma_f32_16x16x32_bf16 v[20:23], v[120:123], v[80:83], v[20:23]
  ds_read_b64_tr_b16 v[104:105], v13 offset:49152
  ds_read_b64_tr_b16 v[106:107], v13 offset:51200
  v_mfma_f32_16x16x32_bf16 v[24:27], v[124:127], v[80:83], v[24:27]
  ds_read_b64_tr_b16 v[108:109], v14 offset:49152
  ds_read_b64_tr_b16 v[110:111], v14 offset:51200
  v_mfma_f32_16x16x32_bf16 v[28:31], v[128:131], v[80:83], v[28:31]
  ds_read_b64_tr_b16 v[112:113], v15 offset:49152
  ds_read_b64_tr_b16 v[114:115], v15 offset:51200
  s_waitcnt vmcnt(2) lgkmcnt(8)
  v_max3_u32 v33, v33, v84, v85
  v_max3_u32 v33, v33, v86, v87
  v_mfma_f32_16x16x32_bf16 v[16:19], v[132:135], v[84:87], v[16:19]
  ds_read_b64_tr_b16 v[116:117], v12 offset:53248
  ds_read_b64_tr_b16 v[118:119], v12 offset:55296
  v_mfma_f32_16x16x32_bf16 v[20:23], v[136:139], v[84:87], v[20:23]
  ds_read_b64_tr_b16 v[120:121], v13 offset:53248
  ds_read_b64_tr_b16 v[122:123], v13 offset:55296
  v_mfma_f32_16x16x32_bf16 v[24:27], v[140:143], v[84:87], v[24:27]
  ds_read_b64_tr_b16 v[124:125], v14 offset:53248
  ds_read_b64_tr_b16 v[126:127], v14 offset:55296
  v_mfma_f32_16x16x32_bf16 v[28:31], v[144:147], v[84:87], v[28:31]
  ds_read_b64_tr_b16 v[128:129], v15 offset:53248
  ds_read_b64_tr_b16 v[130:131], v15 offset:55296
  s_waitcnt vmcnt(1) lgkmcnt(8)
  v_max3_u32 v33, v33, v88, v89
  v_max3_u32 v33, v33, v90, v91
  v_mfma_f32_16x16x32_bf16 v[16:19], v[100:103], v[88:91], v[16:19]
  v_mfma_f32_16x16x32_bf16 v[20:23], v[104:107], v[88:91], v[20:23]
  v_mfma_f32_16x16x32_bf16 v[24:27], v[108:111], v[88:91], v[24:27]
  v_mfma_f32_16x16x32_bf16 v[28:31], v[112:115], v[88:91], v[28:31]
  s_waitcnt vmcnt(0) lgkmcnt(0)
  v_max3_u32 v33, v33, v92, v93
  v_max3_u32 v33, v33, v94, v95
  v_mfma_f32_16x16x32_bf16 v[16:19], v[116:119], v[92:95], v[16:19]
  v_mfma_f32_16x16x32_bf16 v[20:23], v[120:123], v[92:95], v[20:23]
  v_mfma_f32_16x16x32_bf16 v[24:27], v[124:127], v[92:95], v[24:27]
  v_mfma_f32_16x16x32_bf16 v[28:31], v[128:131], v[92:95], v[28:31]
  v_cmp_eq_u32 vcc, -1, v33
  s_add_u32 s59, s59, 1
  s_cmp_ge_u32 s59, 40000
  s_cbranch_scc1 p2c_round_ok
  s_cbranch_vccnz p2c_retry
p2c_round_ok:
  s_movk_i32 s60, 0xff
  s_lshr_b32 s56, s47, 1
  s_cmp_eq_u32 s56, s44
  s_nop 2
  v_bfi_b32 v24, s60, v35, v24
  v_bfi_b32 v26, s60, v36, v26
  v_bfi_b32 v28, s60, v35, v28
  v_bfi_b32 v30, s60, v36, v30
  buffer_store_dwordx4 v[24:27], v11, s[36:39], s53 offen sc1
  buffer_store_dwordx4 v[28:31], v11, s[36:39], s53 offen offset:1024 sc1
  s_cbranch_scc1 p2c_own
  v_bfi_b32 v16, s60, v35, v16
  v_bfi_b32 v18, s60, v36, v18
  v_bfi_b32 v20, s60, v35, v20
  v_bfi_b32 v22, s60, v36, v22
  buffer_store_dwordx4 v[16:19], v11, s[36:39], s57 offen sc1
  buffer_store_dwordx4 v[20:23], v11, s[36:39], s57 offen offset:1024 sc1
  s_branch p2c_fin
p2c_own:
  s_mov_b32 s59, 0
p2c_in:
  buffer_load_dwordx4 v[40:43], v11, s[36:39], s73 offen sc1
  buffer_load_dwordx4 v[44:47], v11, s[36:39], s73 offen offset:1024 sc1
  buffer_load_dwordx4 v[48:51], v11, s[36:39], s74 offen sc1
  buffer_load_dwordx4 v[52:55], v11, s[36:39], s74 offen offset:1024 sc1
  buffer_load_dwordx4 v[56:59], v11, s[36:39], s75 offen sc1
  buffer_load_dwordx4 v[60:63], v11, s[36:39], s75 offen offset:1024 sc1
  buffer_load_dwordx4 v[64:67], v11, s[36:39], s76 offen sc1
  buffer_load_dwordx4 v[68:71], v11, s[36:39], s76 offen offset:1024 sc1
  buffer_load_dwordx4 v[72:75], v11, s[36:39], s77 offen sc1
  buffer_load_dwordx4 v[76:79], v11, s[36:39], s77 offen offset:1024 sc1
  buffer_load_dwordx4 v[80:83], v11, s[36:39], s78 offen sc1
  buffer_load_dwordx4 v[84:87], v11, s[36:39], s78 offen offset:1024 sc1
  buffer_load_dwordx4 v[88:91], v11, s[36:39], s79 offen sc1
  buffer_load_dwordx4 v[92:95], v11, s[36:39], s79 offen offset:1024 sc1
  s_add_u32 s59, s59, 1
  v_mov_b32 v33, 0
  s_waitcnt vmcnt(13)
  v_bitop3_b32 v33, v33, v40, v35 bitop3:0xf6
  v_bitop3_b32 v33, v33, v42, v36 bitop3:0xf6
  s_waitcnt vmcnt(12)
  v_bitop3_b32 v33, v33, v44, v35 bitop3:0xf6
  v_bitop3_b32 v33, v33, v46, v36 bitop3:0xf6
  s_waitcnt vmcnt(11)
  v_bitop3_b32 v33, v33, v48, v35 bitop3:0xf6
  v_bitop3_b32 v33, v33, v50, v36 bitop3:0xf6
  s_waitcnt vmcnt(10)
  v_bitop3_b32 v33, v33, v52, v35 bitop3:0xf6
  v_bitop3_b32 v33, v33, v54, v36 bitop3:0xf6
  s_waitcnt vmcnt(9)
  v_bitop3_b32 v33, v33, v56, v35 bitop3:0xf6
  v_bitop3_b32 v33, v33, v58, v36 bitop3:0xf6
  s_waitcnt vmcnt(8)
  v_bitop3_b32 v33, v33, v60, v35 bitop3:0xf6
  v_bitop3_b32 v33, v33, v62, v36 bitop3:0xf6
  s_waitcnt vmcnt(7)
  v_bitop3_b32 v33, v33, v64, v35 bitop3:0xf6
  v_bitop3_b32 v33, v33, v66, v36 bitop3:0xf6
  s_waitcnt vmcnt(6)
  v_bitop3_b32 v33, v33, v68, v35 bitop3:0xf6
  v_bitop3_b32 v33, v33, v70, v36 bitop3:0xf6
  s_waitcnt vmcnt(5)
  v_bitop3_b32 v33, v33, v72, v35 bitop3:0xf6
  v_bitop3_b32 v33, v33, v74, v36 bitop3:0xf6
  s_waitcnt vmcnt(4)
  v_bitop3_b32 v33, v33, v76, v35 bitop3:0xf6
  v_bitop3_b32 v33, v33, v78, v36 bitop3:0xf6
  s_waitcnt vmcnt(3)
  v_bitop3_b32 v33, v33, v80, v35 bitop3:0xf6
  v_bitop3_b32 v33, v33, v82, v36 bitop3:0xf6
  s_waitcnt vmcnt(2)
  v_bitop3_b32 v33, v33, v84, v35 bitop3:0xf6
  v_bitop3_b32 v33, v33, v86, v36 bitop3:0xf6
  s_waitcnt vmcnt(1)
  v_bitop3_b32 v33, v33, v88, v35 bitop3:0xf6
  v_bitop3_b32 v33, v33, v90, v36 bitop3:0xf6
  s_waitcnt vmcnt(0)
  v_bitop3_b32 v33, v33, v92, v35 bitop3:0xf6
  v_bitop3_b32 v33, v33, v94, v36 bitop3:0xf6
  v_and_b32 v33, 0xff, v33
  v_cmp_ne_u32 vcc, 0, v33
  s_cmp_ge_u32 s59, 40000
  s_cbranch_scc1 p2c_in_ok
  s_cbranch_vccnz p2c_in
p2c_in_ok:
  s_mov_b32 s60, 0xffffff00
  v_and_b32 v40, s60, v40
  v_and_b32 v42, s60, v42
  v_pk_add_f32 v[16:17], v[16:17], v[40:41]
  v_pk_add_f32 v[18:19], v[18:19], v[42:43]
  v_and_b32 v44, s60, v44
  v_and_b32 v46, s60, v46
  v_pk_add_f32 v[20:21], v[20:21], v[44:45]
  v_pk_add_f32 v[22:23], v[22:23], v[46:47]
  v_and_b32 v48, s60, v48
  v_and_b32 v50, s60, v50
  v_pk_add_f32 v[16:17], v[16:17], v[48:49]
  v_pk_add_f32 v[18:19], v[18:19], v[50:51]
  v_and_b32 v52, s60, v52
  v_and_b32 v54, s60, v54
  v_pk_add_f32 v[20:21], v[20:21], v[52:53]
  v_pk_add_f32 v[22:23], v[22:23], v[54:55]
  v_and_b32 v56, s60, v56
  v_and_b32 v58, s60, v58
  v_pk_add_f32 v[16:17], v[16:17], v[56:57]
  v_pk_add_f32 v[18:19], v[18:19], v[58:59]
  v_and_b32 v60, s60, v60
  v_and_b32 v62, s60, v62
  v_pk_add_f32 v[20:21], v[20:21], v[60:61]
  v_pk_add_f32 v[22:23], v[22:23], v[62:63]
  v_and_b32 v64, s60, v64
  v_and_b32 v66, s60, v66
  v_pk_add_f32 v[16:17], v[16:17], v[64:65]
  v_pk_add_f32 v[18:19], v[18:19], v[66:67]
  v_and_b32 v68, s60, v68
  v_and_b32 v70, s60, v70
  v_pk_add_f32 v[20:21], v[20:21], v[68:69]
  v_pk_add_f32 v[22:23], v[22:23], v[70:71]
  v_and_b32 v72, s60, v72
  v_and_b32 v74, s60, v74
  v_pk_add_f32 v[16:17], v[16:17], v[72:73]
  v_pk_add_f32 v[18:19], v[18:19], v[74:75]
  v_and_b32 v76, s60, v76
  v_and_b32 v78, s60, v78
  v_pk_add_f32 v[20:21], v[20:21], v[76:77]
  v_pk_add_f32 v[22:23], v[22:23], v[78:79]
  v_and_b32 v80, s60, v80
  v_and_b32 v82, s60, v82
  v_pk_add_f32 v[16:17], v[16:17], v[80:81]
  v_pk_add_f32 v[18:19], v[18:19], v[82:83]
  v_and_b32 v84, s60, v84
  v_and_b32 v86, s60, v86
  v_pk_add_f32 v[20:21], v[20:21], v[84:85]
  v_pk_add_f32 v[22:23], v[22:23], v[86:87]
  v_and_b32 v88, s60, v88
  v_and_b32 v90, s60, v90
  v_pk_add_f32 v[16:17], v[16:17], v[88:89]
  v_pk_add_f32 v[18:19], v[18:19], v[90:91]
  v_and_b32 v92, s60, v92
  v_and_b32 v94, s60, v94
  v_pk_add_f32 v[20:21], v[20:21], v[92:93]
  v_pk_add_f32 v[22:23], v[22:23], v[94:95]
  v_cvt_pk_bf16_f32 v4, v16, v17
  v_cvt_pk_bf16_f32 v5, v18, v19
  buffer_store_dwordx2 v[4:5], v10, s[40:43], s61 offen
  v_cvt_pk_bf16_f32 v6, v20, v21
  v_cvt_pk_bf16_f32 v7, v22, v23
  buffer_store_dwordx2 v[6:7], v10, s[40:43], s61 offen offset:32
p2c_fin:
  s_endpgm
k_exit:
  s_waitcnt lgkmcnt(0)
k_end:
  s_endpgm
.section .rodata,"a"
.p2align 6
.amdhsa_kernel standalone__glu_gated_glu__sampling_kernel
  .amdhsa_next_free_vgpr 152
  .amdhsa_next_free_sgpr 102
  .amdhsa_accum_offset 152
  .amdhsa_float_denorm_mode_32 3
  .amdhsa_group_segment_fixed_size 0
  .amdhsa_kernarg_size 56
  .amdhsa_user_sgpr_count 2
  .amdhsa_user_sgpr_kernarg_segment_ptr 1
  .amdhsa_system_sgpr_workgroup_id_x 1
.end_amdhsa_kernel
```
